```python
import torch

def _softmax(x, axis=-1):
    return torch.softmax(x, dim=axis)
def _gelu(x):
    return torch.nn.functional.gelu(x, approximate="tanh")
def _silu(x):
    return torch.nn.functional.silu(x)
def _sigmoid(x):
    return torch.sigmoid(x)
def _layernorm(x, axis=-1, eps=1e-5):
    m = x.mean(dim=axis, keepdim=True)
    v = x.var(dim=axis, keepdim=True, unbiased=False)
    return (x - m) / torch.sqrt(v + eps)
def _scatter_add(tgt, idx, src, axis=0):
    return tgt.clone().index_add_(axis, idx, src)
def _segment_sum(src, seg, n):
    out = torch.zeros((n,) + src.shape[1:], dtype=src.dtype)
    return out.index_add_(0, seg, src)
def _pad(x, pw):
    flat = tuple(v for pair in reversed(pw) for v in pair)
    return torch.nn.functional.pad(x, flat)

kernel_name = 'gated_mix__sliding_block_cached__dense_activation_relu__decode'

def setup_inputs():

    _w = (lambda a: (lambda t: t.to(torch.bfloat16) if t.is_floating_point() else t)(torch.as_tensor(a)))
    def _A_setup():
        B, Sq, D = 2, 1, 448
        Hq, Hkv, Sk, Dh = 16, 8, 4096, 256
        assert Hq % Hkv == 0, (Hq, Hkv)
        return {
            "x": _w((lambda *s: torch.randn(*s, dtype=torch.bfloat16) * 0.05)(B, Sq, D)),
            "k_cache": _w((lambda *s: torch.randn(*s, dtype=torch.bfloat16) * 6.4)(B, Hkv, Sk, Dh)),
            "v_cache": _w((lambda *s: torch.randn(*s, dtype=torch.bfloat16) * 0.4)(B, Hkv, Sk, Dh)),
            "wq": _w((lambda *s: torch.randn(*s, dtype=torch.bfloat16) * 6.4)(D, Hq * Dh) * (D ** -0.5)),
            "wo": _w((lambda *s: torch.randn(*s, dtype=torch.bfloat16) * 0.4)(Hq * Dh, D) * ((Hq * Dh) ** -0.5)),
        }
    _A_in = _A_setup()

    def _B_setup():
        B, S, D, Dff = 2, 1, 448, 1792
        return {
            "x": _w((lambda *s: torch.randn(*s, dtype=torch.bfloat16) * 0.05)(B, S, D)),
            "w1": _w((lambda *s: torch.randn(*s, dtype=torch.bfloat16) * 0.05)(D, Dff)),
            "w2": _w((lambda *s: torch.randn(*s, dtype=torch.bfloat16) * 0.05)(Dff, D)),
        }
    _B_in = _B_setup()

    return {
        "A_x": _A_in["x"],
        "A_k_cache": _A_in["k_cache"],
        "A_v_cache": _A_in["v_cache"],
        "A_wq": _A_in["wq"],
        "A_wo": _A_in["wo"],
        "B_x": _B_in["x"],
        "B_w1": _B_in["w1"],
        "B_w2": _B_in["w2"],
        "gate_w": _w((lambda *s: torch.randn(*s, dtype=torch.bfloat16) * 0.05)(448) * 16.0),
    }

def reference(A_x, A_k_cache, A_v_cache, A_wq, A_wo, B_x, B_w1, B_w2, gate_w):
    def _A_ref(x, k_cache, v_cache, wq, wo):
        B, Sq, D = x.shape
        Hq, Dh = 16, 256
        Hkv, Sk = k_cache.shape[1], k_cache.shape[2]
        W = min(4096, max(256, Sk // 4))
        rep = Hq // Hkv
        q = (lambda x, *d: x.permute(*d))((x @ wq).reshape(B, Sq, Hq, Dh), 0, 2, 1, 3)
        k = (lambda x, n, axis: torch.repeat_interleave(x, n, dim=axis))(k_cache[:, :, Sk - W:, :], rep, axis=1)
        v = (lambda x, n, axis: torch.repeat_interleave(x, n, dim=axis))(v_cache[:, :, Sk - W:, :], rep, axis=1)
        scores = torch.einsum("bhqd,bhkd->bhqk", q, k) * (Dh ** -0.5)
        p = _softmax(scores, axis=-1)
        o = torch.einsum("bhqk,bhkd->bhqd", p, v)
        return (lambda x, *d: x.permute(*d))(o, 0, 2, 1, 3).reshape(B, Sq, Hq * Dh) @ wo

    def _B_ref(x, w1, w2):
        h = torch.einsum("bsd,df->bsf", x, w1)
        zero = torch.zeros_like(h)
        h = torch.maximum(h, zero)
        return torch.einsum("bsf,fd->bsd", h, w2)

    x = A_x
    g = _sigmoid((x * gate_w).sum(-1, keepdims=True))
    a = _A_ref(x, A_k_cache, A_v_cache, A_wq, A_wo)
    b = _B_ref(x, B_w1, B_w2)
    return g * a + (1 - g) * b
```

```asm
; @launch grid=(256,1,1) block=(320,1,1) lds=51328
.amdgcn_target "amdgcn-amd-amdhsa--gfx950"
.text
.globl gated_mix__sliding_block_cached__dense_activation_relu__decode_kernel
.p2align 8
.type gated_mix__sliding_block_cached__dense_activation_relu__decode_kernel,@function
gated_mix__sliding_block_cached__dense_activation_relu__decode_kernel:
    s_cmp_ge_u32 s2, 256
    s_cbranch_scc1 L_end
    s_load_dwordx16 s[4:19], s[0:1], 0
    s_load_dwordx8 s[20:27], s[0:1], 64
    v_lshrrev_b32 v4, 6, v0
    v_and_b32 v0, 63, v0
    v_readfirstlane_b32 s3, v4
    v_and_b32 v1, 15, v0
    v_lshrrev_b32 v2, 4, v0
    s_and_b32 s28, s2, 7
    s_lshr_b32 s29, s2, 3
    s_lshr_b32 s30, s29, 4
    s_and_b32 s31, s29, 15
    s_lshr_b32 s52, s29, 2
    s_and_b32 s53, s29, 3
    s_mov_b32 s40, 0x07060500
    s_mov_b32 s41, 0x07060501
    s_mov_b32 s42, 0x07060502
    s_mov_b32 s43, 0x07060503
    s_mov_b32 s44, 0x0c0c0400
    s_mov_b32 s45, 0x04000c0c
    s_mov_b32 s101, 0xffffff00
    s_mov_b32 s46, 1000000
    s_cmp_eq_u32 s53, 3
    s_cselect_b32 s60, 7, 15
    s_cmp_eq_u32 s3, 4
    s_cbranch_scc1 L_aux

    v_lshrrev_b32 v140, 5, v0
    v_and_b32 v141, 31, v0
    v_xor_b32 v142, v141, v140
    v_lshlrev_b32 v142, 4, v142
    v_lshl_add_u32 v104, v140, 9, v142
    v_lshlrev_b32 v143, 4, v1
    v_lshl_add_u32 v8, v2, 11, v143
    s_lshl_b32 s32, s3, 13
    s_lshl_b32 s33, s30, 3
    s_add_u32 s33, s33, s28
    s_lshl_b32 s33, s33, 21
    s_add_u32 s33, s33, 1572864
    s_lshl_b32 s34, s31, 15
    s_add_u32 s33, s33, s34
    s_add_u32 s33, s33, s32
    s_mov_b32 s59, 0x3db8aa3b
    v_mov_b32 v144, 0

s_add_u32 s63, s28, s31
s_and_b32 s63, s63, 7
    s_mul_i32 s34, s63, 1056
    v_xor_b32 v104, s34, v104
    s_lshl_b32 s34, s63, 8
    v_xor_b32 v8, s34, v8
    s_lshl_b32 s34, s63, 10
    s_xor_b32 s38, s32, s34
    s_waitcnt lgkmcnt(0)

global_load_dword v3, v144, s[26:27] sc1
    s_add_u32 s48, s6, s33
    s_addc_u32 s49, s7, 0
    s_add_u32 s50, s8, s33
    s_addc_u32 s51, s9, 0
    s_add_u32 s14, s26, 2097152
    s_addc_u32 s15, s27, 0

s_barrier
s_xor_b32 m0, s38, 0
v_xor_b32 v151, 0, v104
global_load_lds_dwordx4 v151, s[48:49] nt
s_xor_b32 m0, s38, 1024
v_xor_b32 v152, 1056, v104
global_load_lds_dwordx4 v152, s[48:49] nt
s_xor_b32 m0, s38, 2048
v_xor_b32 v151, 2112, v104
global_load_lds_dwordx4 v151, s[48:49] nt
s_xor_b32 m0, s38, 3072
v_xor_b32 v152, 3168, v104
global_load_lds_dwordx4 v152, s[48:49] nt
s_xor_b32 m0, s38, 4096
v_xor_b32 v151, 4224, v104
global_load_lds_dwordx4 v151, s[48:49] nt
    s_movk_i32 s47, 896
    v_and_b32 v9, s60, v1
    v_lshlrev_b32 v9, 4, v9
    v_mad_u32_u24 v9, v2, s47, v9
    s_lshr_b32 s33, s63, 1
    v_xor_b32 v146, s33, v1
    v_xor_b32 v145, v2, v146
    v_lshlrev_b32 v145, 4, v145
    v_lshl_add_u32 v11, v146, 9, v145
    v_add_u32 v11, s32, v11
    v_lshrrev_b32 v145, 3, v1
    v_lshlrev_b32 v146, 9, v145
    v_lshl_add_u32 v10, v2, 4, v146
    s_lshl_b32 s33, s3, 2
    v_lshlrev_b32 v160, 4, v145
    v_add_u32 v160, s33, v160

    v_and_b32 v146, 1, v0
    v_cmp_eq_u32 vcc, 1, v146
    v_mov_b32 v147, 0xffff
    v_mov_b32 v148, 0xffff0000
    v_cndmask_b32 v147, v147, v148, vcc
    v_bfe_u32 v148, v0, 1, 2

    v_cmp_eq_u32 vcc, 0, v148
    s_nop 1
    v_cndmask_b32 v4, 0, v147, vcc

    v_cmp_eq_u32 vcc, 1, v148
    s_nop 1
    v_cndmask_b32 v5, 0, v147, vcc

    v_cmp_eq_u32 vcc, 2, v148
    s_nop 1
    v_cndmask_b32 v6, 0, v147, vcc

    v_cmp_eq_u32 vcc, 3, v148
    s_nop 1
    v_cndmask_b32 v7, 0, v147, vcc

    s_lshl_b32 s33, s28, 14
    s_lshl_b32 s34, s30, 11
    s_add_u32 s33, s33, s34
    s_lshl_b32 s34, s3, 9
    s_add_u32 s33, s33, s34
    s_add_u32 s33, s33, 4096
    v_lshlrev_b32 v12, 12, v140
    v_lshl_add_u32 v12, v141, 4, v12
    v_add_u32 v12, s33, v12
    v_add_u32 v162, 8192, v12
    s_lshl_b32 s33, s3, 8
    v_lshlrev_b32 v13, 3, v141
    v_lshl_add_u32 v13, v140, 2, v13
    v_add_u32 v13, s33, v13
    v_and_b32 v146, 1, v2
    v_lshlrev_b32 v146, 4, v146
    v_lshl_add_u32 v146, v1, 5, v146
    v_add_u32 v146, s32, v146
    v_lshl_add_u32 v14, v140, 10, v146
    s_and_b32 s33, s63, 1
    s_lshl_b32 s33, s33, 9
    v_xor_b32 v14, s33, v14
    v_lshl_add_u32 v18, v140, 9, v146
    s_and_b32 s33, s3, 1
    s_lshl_b32 s35, s33, 10
    v_lshlrev_b32 v15, 4, v0
    v_add_u32 v15, s35, v15
    s_lshl_b32 s35, s28, 1
    s_add_u32 s35, s35, s33
    s_lshl_b32 s34, s35, 1
    s_add_u32 s34, s34, s30
    s_lshl_b32 s34, s34, 8
    s_lshl_b32 s47, s31, 4
    s_add_u32 s34, s34, s47
    s_add_u32 s97, s34, 688128
    s_lshl_b32 s35, s35, 15
    s_lshl_b32 s47, s30, 10
    s_add_u32 s35, s35, s47
    s_lshl_b32 s47, s31, 6
    s_add_u32 s35, s35, s47
    s_add_u32 s35, s35, 1048576
    v_lshrrev_b32 v146, 2, v0
    v_lshlrev_b32 v16, 11, v146
    v_and_b32 v147, 3, v0
    v_lshl_add_u32 v16, v147, 4, v16
    v_add_u32 v16, s35, v16
    s_lshr_b32 s33, s52, 2
    s_lshl_b32 s34, s28, 1
    s_add_u32 s33, s33, s34
    s_and_b32 s34, s52, 3
    s_lshl_b32 s34, s34, 2
    s_add_u32 s34, s34, s3
    s_lshl_b32 s35, s33, 15
    s_lshl_b32 s34, s34, 11
    s_add_u32 s35, s35, s34
    s_add_u32 s35, s35, 1048576
    v_bfe_u32 v146, v0, 2, 1
    v_lshl_add_u32 v146, v2, 1, v146
    v_lshlrev_b32 v17, 10, v145
    v_lshl_add_u32 v17, v146, 6, v17
    v_lshl_add_u32 v17, v147, 4, v17
    v_add_u32 v17, s35, v17
    s_lshl_b32 s33, s33, 9
    s_add_u32 s33, s33, 688128
    v_lshlrev_b32 v163, 8, v145
    v_lshl_add_u32 v163, v146, 4, v163
    v_add_u32 v163, s33, v163
    v_lshlrev_b32 v19, 9, v140
    v_lshl_add_u32 v19, v141, 4, v19
    s_lshl_b32 s33, s28, 3
    s_add_u32 s33, s33, s52
    s_lshl_b32 s33, s33, 12
    s_lshl_b32 s34, s53, 10
    s_add_u32 s33, s33, s34
    s_add_u32 s33, s33, 393216
    v_lshlrev_b32 v20, 4, v0
    v_add_u32 v20, s33, v20
    s_lshr_b32 s33, s29, 3
    s_lshl_b32 s33, s33, 3
    s_add_u32 s55, s33, s28
    s_cmp_ge_u32 s55, 14
    s_cselect_b32 s34, 1, 0
    s_mul_i32 s35, s34, 14
    s_sub_u32 s35, s55, s35
    s_lshl_b32 s47, s35, 3
    s_and_b32 s33, s29, 7
    s_add_u32 s47, s47, s33
    s_lshr_b32 s33, s47, 5
    s_lshl_b32 s33, s33, 10
    s_and_b32 s35, s47, 31
    s_lshl_b32 s35, s35, 4
    s_add_u32 s33, s33, s35
    s_lshl_b32 s35, s34, 9
    s_add_u32 s33, s33, s35
    s_add_u32 s33, s33, 393216
    v_lshlrev_b32 v21, 12, v0
    v_add_u32 v21, s33, v21
    s_mul_i32 s34, s34, 896
    s_lshl_b32 s47, s47, 3
    s_add_u32 s34, s34, s47
    v_lshlrev_b32 v22, 1, v2
    v_add_u32 v22, s34, v22
    s_lshl_b32 s33, s28, 9
    s_lshl_b32 s34, s52, 6
    s_add_u32 s33, s33, s34
    s_lshl_b32 s34, s3, 4
    s_add_u32 s33, s33, s34
    s_mul_i32 s33, s33, 896
    s_lshl_b32 s34, s53, 8
    s_add_u32 s33, s33, s34
    s_add_u32 s12, s12, s33
    s_addc_u32 s13, s13, 0
    s_add_u32 s36, s12, 7168
    s_addc_u32 s37, s13, 0

s_waitcnt vmcnt(4)
v_add_u32 v3, 0x01010101, v3
s_xor_b32 m0, s38, 5120
v_xor_b32 v152, 5280, v104
global_load_lds_dwordx4 v152, s[48:49] nt
s_waitcnt vmcnt(4)
s_xor_b32 m0, s38, 6144
v_xor_b32 v151, 6336, v104
global_load_lds_dwordx4 v151, s[48:49] nt
s_waitcnt vmcnt(4)
s_xor_b32 m0, s38, 7168
v_xor_b32 v152, 7392, v104
global_load_lds_dwordx4 v152, s[48:49] nt
s_waitcnt vmcnt(4)
v_xor_b32 v151, 0, v8
global_load_dwordx4 v[24:27], v151, s[50:51] nt
s_waitcnt vmcnt(4)
v_xor_b32 v152, 256, v8
global_load_dwordx4 v[28:31], v152, s[50:51] nt
s_waitcnt vmcnt(4)
v_xor_b32 v151, 512, v8
global_load_dwordx4 v[32:35], v151, s[50:51] nt
s_waitcnt vmcnt(4)
v_xor_b32 v152, 768, v8
global_load_dwordx4 v[36:39], v152, s[50:51] nt
s_waitcnt vmcnt(4)
global_load_dwordx4 v[140:143], v12, s[26:27] sc1
global_load_dwordx4 v[164:167], v162, s[26:27] sc1
v_xor_b32 v144, 0, v11
ds_read_b128 v[72:75], v144
v_xor_b32 v145, 64, v11
ds_read_b128 v[76:79], v145
v_xor_b32 v144, 128, v11
ds_read_b128 v[80:83], v144
v_xor_b32 v145, 192, v11
ds_read_b128 v[84:87], v145
v_xor_b32 v144, 256, v11
ds_read_b128 v[88:91], v144
v_xor_b32 v145, 320, v11
ds_read_b128 v[92:95], v145
v_xor_b32 v144, 384, v11
ds_read_b128 v[96:99], v144
v_xor_b32 v145, 448, v11
ds_read_b128 v[100:103], v145
s_waitcnt vmcnt(4)
v_xor_b32 v151, 1024, v8
global_load_dwordx4 v[40:43], v151, s[50:51] nt
s_waitcnt vmcnt(4)
v_xor_b32 v152, 1280, v8
global_load_dwordx4 v[44:47], v152, s[50:51] nt
s_waitcnt vmcnt(4)
v_xor_b32 v151, 1536, v8
global_load_dwordx4 v[48:51], v151, s[50:51] nt
s_waitcnt vmcnt(4)
v_xor_b32 v152, 1792, v8
global_load_dwordx4 v[52:55], v152, s[50:51] nt
s_waitcnt vmcnt(4)
L_h1_chk:
v_perm_b32 v144, v141, v140, s44
v_perm_b32 v145, v143, v142, s45
v_bitop3_b32 v146, v144, v145, v3 bitop3:0x56
v_perm_b32 v144, v165, v164, s44
v_perm_b32 v145, v167, v166, s45
v_bitop3_b32 v147, v144, v145, v3 bitop3:0x56
v_or_b32 v146, v146, v147
    v_cmp_ne_u32 vcc, 0, v146
    s_cbranch_vccz L_h1_ok

L_h1_r:
    s_sub_u32 s46, s46, 1
    s_cmp_eq_u32 s46, 0
    s_cbranch_scc1 L_h1_ok
    s_mov_b64 exec, vcc

    s_and_b32 s32, s46, 15
    s_cmp_eq_u32 s32, 0
    s_cbranch_scc1 L_h1_r_b

global_load_dwordx4 v[140:143], v12, s[26:27] sc1
global_load_dwordx4 v[164:167], v162, s[26:27] sc1
s_branch L_h1_r_c
L_h1_r_b:
global_load_dwordx4 v[140:143], v12, s[14:15] sc1
global_load_dwordx4 v[164:167], v162, s[14:15] sc1
L_h1_r_c:
s_waitcnt vmcnt(0)
v_perm_b32 v144, v141, v140, s44
v_perm_b32 v145, v143, v142, s45
v_bitop3_b32 v146, v144, v145, v3 bitop3:0x56
v_perm_b32 v144, v165, v164, s44
v_perm_b32 v145, v167, v166, s45
v_bitop3_b32 v147, v144, v145, v3 bitop3:0x56
v_or_b32 v146, v146, v147
    v_cmp_ne_u32 vcc, 0, v146
    s_cbranch_vccnz L_h1_r

L_h1_ok:
s_mov_b64 exec, -1
v_and_b32 v140, s101, v140
v_and_b32 v141, s101, v141
v_and_b32 v142, s101, v142
v_and_b32 v143, s101, v143
v_and_b32 v164, s101, v164
v_and_b32 v165, s101, v165
v_and_b32 v166, s101, v166
v_and_b32 v167, s101, v167
    v_pk_add_f32 v[140:141], v[140:141], v[164:165]
    v_pk_add_f32 v[142:143], v[142:143], v[166:167]
    s_nop 1
    v_permlane32_swap_b32 v140, v142
    v_permlane32_swap_b32 v141, v143
    v_add_f32 v140, v140, v142
    v_add_f32 v141, v141, v143
    v_cvt_pk_bf16_f32 v140, v140, v141
    ds_write_b32 v13, v140 offset:50176

s_waitcnt lgkmcnt(0)
s_barrier
ds_read_b128 v[104:107], v10 offset:50176
ds_read_b128 v[108:111], v10 offset:50240
ds_read_b128 v[112:115], v10 offset:50304
ds_read_b128 v[116:119], v10 offset:50368
ds_read_b128 v[120:123], v10 offset:50432
ds_read_b128 v[124:127], v10 offset:50496
ds_read_b128 v[128:131], v10 offset:50560
ds_read_b128 v[132:135], v10 offset:50624
global_load_dwordx4 v[56:59], v9, s[12:13] nt
s_waitcnt lgkmcnt(7)
v_mfma_f32_16x16x32_bf16 v[136:139], v[72:75], v[104:107], 0
s_waitcnt lgkmcnt(6)
v_mfma_f32_16x16x32_bf16 v[136:139], v[76:79], v[108:111], v[136:139]
s_waitcnt lgkmcnt(5)
v_mfma_f32_16x16x32_bf16 v[136:139], v[80:83], v[112:115], v[136:139]
s_waitcnt lgkmcnt(4)
v_mfma_f32_16x16x32_bf16 v[136:139], v[84:87], v[116:119], v[136:139]
s_waitcnt lgkmcnt(3)
v_mfma_f32_16x16x32_bf16 v[136:139], v[88:91], v[120:123], v[136:139]
s_waitcnt lgkmcnt(2)
v_mfma_f32_16x16x32_bf16 v[136:139], v[92:95], v[124:127], v[136:139]
s_waitcnt lgkmcnt(1)
v_mfma_f32_16x16x32_bf16 v[136:139], v[96:99], v[128:131], v[136:139]
s_waitcnt lgkmcnt(0)
v_mfma_f32_16x16x32_bf16 v[136:139], v[100:103], v[132:135], v[136:139]
global_load_dwordx4 v[60:63], v9, s[12:13] offset:3584 nt
    s_nop 6
    v_cvt_pk_bf16_f32 v140, v136, v137
    v_cvt_pk_bf16_f32 v141, v138, v139
    v_lshlrev_b32 v136, 16, v140
    v_and_b32 v137, 0xffff0000, v140
    v_lshlrev_b32 v138, 16, v141
    v_and_b32 v139, 0xffff0000, v141

    v_max3_f32 v142, v136, v137, v138
    v_max_f32 v142, v142, v139

v_mov_b32 v140, v142
    s_nop 1
v_permlane16_swap_b32 v140, v142
v_max_f32 v142, v142, v140
v_mov_b32 v140, v142
    s_nop 1
v_permlane32_swap_b32 v140, v142
v_max_f32 v142, v142, v140
    v_mul_f32 v142, s59, v142
    v_fma_f32 v136, v136, s59, -v142
    v_fma_f32 v137, v137, s59, -v142
    v_fma_f32 v138, v138, s59, -v142
    v_fma_f32 v139, v139, s59, -v142
    v_exp_f32 v136, v136
    v_exp_f32 v137, v137
    v_exp_f32 v138, v138
    v_exp_f32 v139, v139

v_cvt_pk_bf16_f32 v144, v136, v136
v_cvt_pk_bf16_f32 v145, v137, v137
v_cvt_pk_bf16_f32 v146, v138, v138
v_cvt_pk_bf16_f32 v147, v139, v139
global_load_dwordx4 v[64:67], v9, s[36:37] nt
v_and_b32 v72, v144, v4
v_and_b32 v73, v144, v5
v_and_b32 v74, v144, v6
v_and_b32 v75, v144, v7
v_and_b32 v76, v145, v4
v_and_b32 v77, v145, v5
v_and_b32 v78, v145, v6
v_and_b32 v79, v145, v7
s_waitcnt vmcnt(11)
v_mfma_f32_16x16x32_bf16 v[88:91], v[72:75], v[24:27], 0
v_mfma_f32_16x16x32_bf16 v[92:95], v[72:75], v[28:31], 0
    v_add_f32 v143, v136, v137
    v_add_f32 v148, v138, v139
    v_add_f32 v143, v143, v148

v_and_b32 v80, v146, v4
v_and_b32 v81, v146, v5
v_and_b32 v82, v146, v6
v_and_b32 v83, v146, v7
s_waitcnt vmcnt(9)
v_mfma_f32_16x16x32_bf16 v[88:91], v[76:79], v[32:35], v[88:91]
v_mfma_f32_16x16x32_bf16 v[92:95], v[76:79], v[36:39], v[92:95]
v_mov_b32 v140, v143
    s_nop 1
v_permlane16_swap_b32 v140, v143
v_add_f32 v143, v143, v140
v_mov_b32 v140, v143
    s_nop 1
v_permlane32_swap_b32 v140, v143
v_add_f32 v143, v143, v140
v_and_b32 v84, v147, v4
v_and_b32 v85, v147, v5
v_and_b32 v86, v147, v6
v_and_b32 v87, v147, v7
s_waitcnt vmcnt(5)
v_mfma_f32_16x16x32_bf16 v[88:91], v[80:83], v[40:43], v[88:91]
v_mfma_f32_16x16x32_bf16 v[92:95], v[80:83], v[44:47], v[92:95]
    s_mov_b32 exec_lo, 0x101
    s_mov_b32 exec_hi, 0
    ds_write_b32 v160, v142 offset:51216
    ds_write_b32 v160, v143 offset:51248
    s_mov_b64 exec, -1

s_waitcnt vmcnt(3)
v_mfma_f32_16x16x32_bf16 v[88:91], v[84:87], v[48:51], v[88:91]
v_mfma_f32_16x16x32_bf16 v[92:95], v[84:87], v[52:55], v[92:95]
global_load_dwordx4 v[68:71], v9, s[36:37] offset:3584 nt
    v_xor_b32 v151, 512, v14
    s_and_b32 s32, s3, 1
    s_lshl_b32 s32, s32, 4
    v_mov_b32 v149, s32
    v_lshrrev_b32 v148, 3, v1
    v_lshlrev_b32 v148, 2, v148
    ds_read_b32 v161, v148 offset:51200
    s_nop 1
    ds_write_b128 v14, v[88:91]
    ds_write_b128 v151, v[92:95]
    s_waitcnt lgkmcnt(0)
    s_barrier

s_cmp_ge_u32 s3, 2
s_cbranch_scc1 L_m_nopub
    ds_read_b128 v[140:143], v149 offset:51216
    ds_read_b128 v[144:147], v149 offset:51248

v_mov_b32 v150, 0
ds_read_b32 v150, v150 offset:51280
ds_read_b128 v[96:99], v15 offset:0
ds_read_b128 v[100:103], v15 offset:8192
ds_read_b128 v[104:107], v15 offset:16384
ds_read_b128 v[108:111], v15 offset:24576
s_waitcnt lgkmcnt(4)
v_readfirstlane_b32 s100, v150
    v_max3_f32 v148, v140, v141, v142
    v_max_f32 v148, v148, v143

v_sub_f32 v152, v140, v148
v_sub_f32 v154, v141, v148
v_sub_f32 v156, v142, v148
v_sub_f32 v158, v143, v148
v_exp_f32 v152, v152
v_exp_f32 v154, v154
v_exp_f32 v156, v156
v_exp_f32 v158, v158
v_mul_f32 v149, v152, v144
v_fmac_f32 v149, v154, v145
v_fmac_f32 v149, v156, v146
v_fmac_f32 v149, v158, v147
s_waitcnt lgkmcnt(0)
v_pk_mul_f32 v[96:97], v[96:97], v[152:153] op_sel_hi:[1,0]
v_pk_mul_f32 v[98:99], v[98:99], v[152:153] op_sel_hi:[1,0]
v_pk_fma_f32 v[96:97], v[100:101], v[154:155], v[96:97] op_sel_hi:[1,0,1]
v_pk_fma_f32 v[98:99], v[102:103], v[154:155], v[98:99] op_sel_hi:[1,0,1]
v_pk_fma_f32 v[96:97], v[104:105], v[156:157], v[96:97] op_sel_hi:[1,0,1]
v_pk_fma_f32 v[98:99], v[106:107], v[156:157], v[98:99] op_sel_hi:[1,0,1]
v_pk_fma_f32 v[96:97], v[108:109], v[158:159], v[96:97] op_sel_hi:[1,0,1]
v_pk_fma_f32 v[98:99], v[110:111], v[158:159], v[98:99] op_sel_hi:[1,0,1]
v_perm_b32 v96, v96, v3, s40
v_perm_b32 v97, v97, v3, s41
v_perm_b32 v98, v98, v3, s42
v_perm_b32 v99, v99, v3, s43
global_store_dwordx4 v16, v[96:99], s[26:27]
s_cmp_lg_u32 s100, 0
s_cbranch_scc1 L_skipb_opub
global_store_dwordx4 v16, v[96:99], s[14:15] sc1
L_skipb_opub:
    v_mov_b32 v100, v148
    v_mov_b32 v101, v149
    v_mov_b32 v102, v148
    v_mov_b32 v103, v149
    v_mov_b32 v104, s97

v_perm_b32 v100, v100, v3, s40
v_perm_b32 v101, v101, v3, s41
v_perm_b32 v102, v102, v3, s42
v_perm_b32 v103, v103, v3, s43
s_mov_b64 exec, 1
global_store_dwordx4 v104, v[100:103], s[26:27]
s_cmp_lg_u32 s100, 0
s_cbranch_scc1 L_skipb_mlpub
global_store_dwordx4 v104, v[100:103], s[14:15] sc1
L_skipb_mlpub:
s_mov_b64 exec, -1
L_m_nopub:
s_waitcnt vmcnt(0)
global_load_dwordx4 v[24:27], v163, s[26:27] sc1
global_load_dwordx4 v[28:31], v163, s[26:27] offset:128 sc1
global_load_dwordx4 v[32:35], v17, s[26:27] sc1
global_load_dwordx4 v[36:39], v17, s[26:27] offset:512 sc1
s_waitcnt vmcnt(0)
L_h2_comp:
v_and_b32 v144, s101, v24
v_and_b32 v145, s101, v28
v_max_f32 v146, v144, v145
v_perm_b32 v158, v25, v24, s44
v_perm_b32 v159, v27, v26, s45
v_max_f32_dpp v152, v146, v146 row_shr:4 row_mask:0xf bank_mask:0xa
v_max_f32_dpp v152, v146, v146 row_shl:4 row_mask:0xf bank_mask:0x5
v_mov_b32 v146, v152
v_bitop3_b32 v154, v158, v159, v3 bitop3:0x56
v_perm_b32 v158, v29, v28, s44
v_permlane16_swap_b32 v146, v152
v_max_f32 v146, v146, v152
v_mov_b32 v152, v146
v_perm_b32 v159, v31, v30, s45
v_bitop3_b32 v155, v158, v159, v3 bitop3:0x56
v_permlane32_swap_b32 v146, v152
v_max_f32 v146, v146, v152
v_sub_f32 v140, v144, v146
v_sub_f32 v142, v145, v146
v_exp_f32 v140, v140
v_exp_f32 v142, v142
v_perm_b32 v158, v33, v32, s44
v_perm_b32 v159, v35, v34, s45
v_bitop3_b32 v156, v158, v159, v3 bitop3:0x56
v_perm_b32 v158, v37, v36, s44
v_perm_b32 v159, v39, v38, s45
v_bitop3_b32 v157, v158, v159, v3 bitop3:0x56
v_or3_b32 v153, v154, v155, v156
v_or_b32 v153, v153, v157
    v_cmp_ne_u32 vcc, 0, v153
    s_cbranch_vccz L_h2_ok

L_h2_r:
    s_sub_u32 s46, s46, 1
    s_cmp_eq_u32 s46, 0
    s_cbranch_scc1 L_h2_ok
    s_mov_b64 exec, vcc

    s_and_b32 s32, s46, 15
    s_cmp_eq_u32 s32, 0
    s_cbranch_scc1 L_h2_r_b

global_load_dwordx4 v[24:27], v163, s[26:27] sc1
global_load_dwordx4 v[28:31], v163, s[26:27] offset:128 sc1
global_load_dwordx4 v[32:35], v17, s[26:27] sc1
global_load_dwordx4 v[36:39], v17, s[26:27] offset:512 sc1
s_branch L_h2_r_c
L_h2_r_b:
global_load_dwordx4 v[24:27], v163, s[14:15] sc1
global_load_dwordx4 v[28:31], v163, s[14:15] offset:128 sc1
global_load_dwordx4 v[32:35], v17, s[14:15] sc1
global_load_dwordx4 v[36:39], v17, s[14:15] offset:512 sc1
L_h2_r_c:
s_waitcnt vmcnt(0)
v_perm_b32 v158, v25, v24, s44
v_perm_b32 v159, v27, v26, s45
v_bitop3_b32 v154, v158, v159, v3 bitop3:0x56
v_perm_b32 v158, v29, v28, s44
v_perm_b32 v159, v31, v30, s45
v_bitop3_b32 v155, v158, v159, v3 bitop3:0x56
v_perm_b32 v158, v33, v32, s44
v_perm_b32 v159, v35, v34, s45
v_bitop3_b32 v156, v158, v159, v3 bitop3:0x56
v_perm_b32 v158, v37, v36, s44
v_perm_b32 v159, v39, v38, s45
v_bitop3_b32 v157, v158, v159, v3 bitop3:0x56
v_or3_b32 v153, v154, v155, v156
v_or_b32 v153, v153, v157
    v_cmp_ne_u32 vcc, 0, v153
    s_cbranch_vccnz L_h2_r

    s_mov_b64 exec, -1
    s_branch L_h2_comp
L_h2_ok:
    s_mov_b64 exec, -1

v_and_b32 v25, s101, v25
v_and_b32 v29, s101, v29
v_and_b32 v32, s101, v32
v_and_b32 v33, s101, v33
v_and_b32 v34, s101, v34
v_and_b32 v35, s101, v35
v_and_b32 v36, s101, v36
v_and_b32 v37, s101, v37
v_and_b32 v38, s101, v38
v_and_b32 v39, s101, v39
    v_mul_f32 v147, v140, v25
    v_pk_mul_f32 v[148:149], v[32:33], v[140:141] op_sel_hi:[1,0]
    v_pk_mul_f32 v[150:151], v[34:35], v[140:141] op_sel_hi:[1,0]
    v_fmac_f32 v147, v142, v29
    v_pk_fma_f32 v[148:149], v[36:37], v[142:143], v[148:149] op_sel_hi:[1,0,1]
    v_pk_fma_f32 v[150:151], v[38:39], v[142:143], v[150:151] op_sel_hi:[1,0,1]
    v_add_f32_dpp v152, v147, v147 row_shr:4 row_mask:0xf bank_mask:0xa
    v_add_f32_dpp v152, v147, v147 row_shl:4 row_mask:0xf bank_mask:0x5
    v_mov_b32 v147, v152
    v_permlane32_swap_b32 v148, v150
    v_permlane32_swap_b32 v149, v151
    v_permlane16_swap_b32 v147, v152
    v_add_f32 v148, v148, v150
    v_add_f32 v149, v149, v151
    v_add_f32 v147, v147, v152
    v_mov_b32 v152, v147
    v_permlane16_swap_b32 v148, v149
    s_nop 0
    v_permlane32_swap_b32 v147, v152
    v_add_f32 v148, v148, v149
    v_add_f32 v147, v147, v152
    v_rcp_f32 v147, v147
    v_add_f32_dpp v152, v148, v148 row_shr:4 row_mask:0xf bank_mask:0xa
    v_add_f32_dpp v152, v148, v148 row_shl:4 row_mask:0xf bank_mask:0x5
    v_mul_f32 v147, v147, v161
    v_mul_f32 v148, v152, v147
    v_cvt_pk_bf16_f32 v148, v148, v148

    s_nop 1
v_and_b32_dpp v72, v148, v4 quad_perm:[0,0,0,0] row_mask:0xf bank_mask:0xf
v_and_b32_dpp v73, v148, v5 quad_perm:[0,0,0,0] row_mask:0xf bank_mask:0xf
v_and_b32_dpp v74, v148, v6 quad_perm:[0,0,0,0] row_mask:0xf bank_mask:0xf
v_and_b32_dpp v75, v148, v7 quad_perm:[0,0,0,0] row_mask:0xf bank_mask:0xf
v_and_b32_dpp v76, v148, v4 quad_perm:[1,1,1,1] row_mask:0xf bank_mask:0xf
v_and_b32_dpp v77, v148, v5 quad_perm:[1,1,1,1] row_mask:0xf bank_mask:0xf
v_and_b32_dpp v78, v148, v6 quad_perm:[1,1,1,1] row_mask:0xf bank_mask:0xf
v_and_b32_dpp v79, v148, v7 quad_perm:[1,1,1,1] row_mask:0xf bank_mask:0xf
v_mfma_f32_16x16x32_bf16 v[88:91], v[72:75], v[56:59], 0
v_and_b32_dpp v80, v148, v4 quad_perm:[2,2,2,2] row_mask:0xf bank_mask:0xf
v_and_b32_dpp v81, v148, v5 quad_perm:[2,2,2,2] row_mask:0xf bank_mask:0xf
v_and_b32_dpp v82, v148, v6 quad_perm:[2,2,2,2] row_mask:0xf bank_mask:0xf
v_and_b32_dpp v83, v148, v7 quad_perm:[2,2,2,2] row_mask:0xf bank_mask:0xf
v_mfma_f32_16x16x32_bf16 v[88:91], v[76:79], v[60:63], v[88:91]
v_and_b32_dpp v84, v148, v4 quad_perm:[3,3,3,3] row_mask:0xf bank_mask:0xf
v_and_b32_dpp v85, v148, v5 quad_perm:[3,3,3,3] row_mask:0xf bank_mask:0xf
v_and_b32_dpp v86, v148, v6 quad_perm:[3,3,3,3] row_mask:0xf bank_mask:0xf
v_and_b32_dpp v87, v148, v7 quad_perm:[3,3,3,3] row_mask:0xf bank_mask:0xf
v_mfma_f32_16x16x32_bf16 v[88:91], v[80:83], v[64:67], v[88:91]
    s_nop 0
v_mfma_f32_16x16x32_bf16 v[88:91], v[84:87], v[68:71], v[88:91]
    s_nop 7
    ds_write_b128 v18, v[88:91] offset:4096
    s_waitcnt lgkmcnt(0)
    s_barrier
    s_cmp_lg_u32 s3, 0
    s_cbranch_scc1 L_m_done

ds_read_b128 v[96:99], v19 offset:4096
ds_read_b128 v[100:103], v19 offset:12288
ds_read_b128 v[104:107], v19 offset:20480
ds_read_b128 v[108:111], v19 offset:28672
    ds_read_b128 v[112:115], v19 offset:32768
    s_waitcnt lgkmcnt(0)
    v_pk_add_f32 v[96:97], v[96:97], v[100:101]
    v_pk_add_f32 v[98:99], v[98:99], v[102:103]
    v_pk_add_f32 v[104:105], v[104:105], v[108:109]
    v_pk_add_f32 v[106:107], v[106:107], v[110:111]
    v_pk_add_f32 v[96:97], v[96:97], v[112:113]
    v_pk_add_f32 v[98:99], v[98:99], v[114:115]
    v_pk_add_f32 v[96:97], v[96:97], v[104:105]
    v_pk_add_f32 v[98:99], v[98:99], v[106:107]

v_perm_b32 v96, v96, v3, s40
v_perm_b32 v97, v97, v3, s41
v_perm_b32 v98, v98, v3, s42
v_perm_b32 v99, v99, v3, s43
global_store_dwordx4 v20, v[96:99], s[26:27] sc1
    s_cmp_ge_u32 s55, 28
    s_cbranch_scc1 L_m_done

s_waitcnt vmcnt(0)
L_h3_loop:
    global_load_dwordx4 v[24:27], v21, s[26:27] sc1
    s_waitcnt vmcnt(0)

v_perm_b32 v142, v25, v24, s44
v_perm_b32 v143, v27, v26, s45
v_bitop3_b32 v144, v142, v143, v3 bitop3:0x56
    v_cmp_ne_u32 vcc, 0, v144
    s_cbranch_vccz L_h3_ok
    s_mov_b64 exec, vcc
    s_sub_u32 s46, s46, 1
    s_cmp_lg_u32 s46, 0
    s_cbranch_scc1 L_h3_loop
L_h3_ok:
    s_mov_b64 exec, -1

v_and_b32 v24, s101, v24
v_and_b32 v25, s101, v25
v_and_b32 v26, s101, v26
v_and_b32 v27, s101, v27
    s_nop 0
    v_permlane32_swap_b32 v24, v26
    v_permlane32_swap_b32 v25, v27
    v_add_f32 v24, v24, v26
    v_add_f32 v25, v25, v27
    s_nop 1
    v_permlane16_swap_b32 v24, v25
    v_add_f32 v24, v24, v25
    s_nop 1
    v_add_f32_dpp v24, v24, v24 row_ror:8 row_mask:0xf bank_mask:0xf
    s_nop 1
    v_add_f32_dpp v24, v24, v24 row_ror:4 row_mask:0xf bank_mask:0xf
    s_nop 1
    v_add_f32_dpp v24, v24, v24 row_ror:2 row_mask:0xf bank_mask:0xf
    s_nop 1
    v_add_f32_dpp v24, v24, v24 row_ror:1 row_mask:0xf bank_mask:0xf
    v_cvt_pk_bf16_f32 v24, v24, v24
    s_mov_b32 exec_lo, 0x00010001
    s_mov_b32 exec_hi, 0x00010001
    global_store_short v22, v24, s[22:23]
    s_cmp_lg_u32 s2, 0
    s_cbranch_scc1 L_m_done
    v_mov_b32 v140, 0
    s_mov_b64 exec, 1
    global_store_dword v140, v3, s[26:27] sc1
L_m_done:
    s_mov_b64 exec, -1

s_branch L_fin
L_aux:
s_setprio 3
    v_lshlrev_b32 v4, 4, v0
    v_bfe_u32 v76, v0, 4, 1
    v_lshlrev_b32 v76, 1, v76
    v_and_b32 v77, 7, v0
    v_xor_b32 v77, v77, v76
    v_lshlrev_b32 v77, 4, v77
    v_lshrrev_b32 v76, 3, v0
    v_lshl_add_u32 v5, v76, 13, v77
    v_xor_b32 v6, 64, v5
    s_and_b32 s32, s29, 3
    s_lshr_b32 s33, s29, 2
    s_mul_i32 s34, s32, 917504
    s_lshl_b32 s35, s28, 10
    s_add_u32 s34, s34, s35
    s_lshl_b32 s35, s33, 7
    s_add_u32 s34, s34, s35
    v_mov_b32 v78, 0
    s_waitcnt lgkmcnt(0)

    s_add_u32 s10, s10, s34
    s_addc_u32 s11, s11, 0
    global_load_dword v3, v78, s[26:27] sc1
    s_mov_b32 m0, 47104
    s_add_u32 s14, s26, 2097152
    global_load_lds_dwordx4 v4, s[4:5]
    s_addc_u32 s15, s27, 0
    s_mov_b32 exec_lo, -1
    s_mov_b32 exec_hi, 0x0000ffff
    global_load_lds_dwordx4 v4, s[4:5] offset:1024
    s_mov_b32 m0, 49152
    s_mov_b32 exec_hi, 0x00ffffff
    global_load_lds_dwordx4 v4, s[20:21]
    s_mov_b64 exec, -1

s_mov_b32 m0, 32768
s_nop 0
global_load_lds_dwordx4 v5, s[10:11] nt
s_mov_b32 m0, 33792
s_add_u32 s10, s10, 65536
s_addc_u32 s11, s11, 0
global_load_lds_dwordx4 v6, s[10:11] nt
s_mov_b32 m0, 34816
s_add_u32 s10, s10, 65536
s_addc_u32 s11, s11, 0
global_load_lds_dwordx4 v5, s[10:11] nt
s_mov_b32 m0, 35840
s_add_u32 s10, s10, 65536
s_addc_u32 s11, s11, 0
global_load_lds_dwordx4 v6, s[10:11] nt
s_mov_b32 m0, 36864
s_add_u32 s10, s10, 65536
s_addc_u32 s11, s11, 0
global_load_lds_dwordx4 v5, s[10:11] nt
s_mov_b32 m0, 37888
s_add_u32 s10, s10, 65536
s_addc_u32 s11, s11, 0
global_load_lds_dwordx4 v6, s[10:11] nt
s_mov_b32 m0, 38912
s_add_u32 s10, s10, 65536
s_addc_u32 s11, s11, 0
global_load_lds_dwordx4 v5, s[10:11] nt
s_mov_b32 m0, 39936
s_add_u32 s10, s10, 65536
s_addc_u32 s11, s11, 0
global_load_lds_dwordx4 v6, s[10:11] nt
s_mov_b32 m0, 40960
s_add_u32 s10, s10, 65536
s_addc_u32 s11, s11, 0
global_load_lds_dwordx4 v5, s[10:11] nt
s_mov_b32 m0, 41984
s_add_u32 s10, s10, 65536
s_addc_u32 s11, s11, 0
global_load_lds_dwordx4 v6, s[10:11] nt
s_mov_b32 m0, 43008
s_add_u32 s10, s10, 65536
s_addc_u32 s11, s11, 0
global_load_lds_dwordx4 v5, s[10:11] nt
s_mov_b32 m0, 44032
s_add_u32 s10, s10, 65536
s_addc_u32 s11, s11, 0
global_load_lds_dwordx4 v6, s[10:11] nt
s_mov_b32 m0, 45056
s_add_u32 s10, s10, 65536
s_addc_u32 s11, s11, 0
global_load_lds_dwordx4 v5, s[10:11] nt
s_mov_b32 m0, 46080
s_add_u32 s10, s10, 65536
s_addc_u32 s11, s11, 0
global_load_lds_dwordx4 v6, s[10:11] nt
s_barrier
    v_lshrrev_b32 v76, 2, v1
    v_lshl_add_u32 v77, v2, 3, v76
    v_lshlrev_b32 v77, 7, v77
    v_and_b32 v78, 3, v1
    v_lshl_add_u32 v77, v78, 3, v77
    v_lshrrev_b32 v76, 1, v76
    v_and_b32 v78, 1, v2
    v_lshl_add_u32 v76, v78, 1, v76
    v_lshl_add_u32 v72, v76, 5, v77
    v_xor_b32 v73, 32, v72
    v_xor_b32 v74, 64, v72
    v_xor_b32 v75, 96, v72
    v_lshrrev_b32 v79, 3, v1
    v_mul_u32_u24 v76, 896, v79
    v_lshl_add_u32 v7, v2, 4, v76
    s_mul_i32 s34, s32, 224
    v_add_u32 v7, s34, v7
    s_lshl_b32 s34, s28, 14
    s_lshl_b32 s35, s32, 12
    s_add_u32 s34, s34, s35
    s_lshl_b32 s35, s33, 8
    s_add_u32 s34, s34, s35
    s_add_u32 s34, s34, 4096
    v_lshlrev_b32 v158, 11, v79
    v_and_b32 v77, 3, v0
    v_lshl_add_u32 v158, v77, 6, v158
    v_lshl_add_u32 v158, v2, 4, v158
    v_add_u32 v158, s34, v158
    v_and_b32 v77, 1, v0
    v_cmp_eq_u32 s[48:49], 1, v77
    v_and_b32 v77, 2, v0
    v_cmp_eq_u32 s[50:51], 2, v77
    v_cmp_gt_u32 s[36:37], 2, v2

    v_and_b32 v80, 1, v0
    v_cmp_eq_u32 vcc, 1, v80
    v_mov_b32 v81, 0xffff
    v_mov_b32 v82, 0xffff0000
    v_cndmask_b32 v81, v81, v82, vcc
    v_bfe_u32 v82, v0, 1, 2

    v_cmp_eq_u32 vcc, 0, v82
    s_nop 1
    v_cndmask_b32 v96, 0, v81, vcc

    v_cmp_eq_u32 vcc, 1, v82
    s_nop 1
    v_cndmask_b32 v97, 0, v81, vcc

    v_cmp_eq_u32 vcc, 2, v82
    s_nop 1
    v_cndmask_b32 v98, 0, v81, vcc

    v_cmp_eq_u32 vcc, 3, v82
    s_nop 1
    v_cndmask_b32 v99, 0, v81, vcc

    s_mov_b32 s57, 0x54763210
    s_lshl_b32 s34, s28, 2
    s_lshr_b32 s57, s57, s34
    s_and_b32 s57, s57, 7
    s_cmp_eq_u32 s52, 4
    s_cselect_b32 s62, 3, s52

    s_cmp_lt_u32 s52, 3
    s_cselect_b32 s58, 1, 0
    s_cmp_eq_u32 s52, 4
    s_cselect_b32 s58, 1, s58
    s_lshl_b32 s39, s62, 2
    s_add_u32 s39, s39, s53
    s_lshl_b32 s34, s57, 1
    s_add_u32 s34, s34, s30
    s_add_u32 s35, s57, 6
    s_cmp_lt_u32 s57, 6
    s_cselect_b32 s35, s34, s35
    s_cselect_b32 s58, 1, s58
    s_cselect_b32 s96, s31, s39
    s_cselect_b32 s62, s52, s62
    s_and_b32 s96, s96, 15
    s_mul_i32 s47, s96, 28
    s_mul_i32 s54, s47, 3584
    s_lshl_b32 s39, s35, 8
    s_add_u32 s54, s54, s39
    s_add_u32 s16, s16, s54
    s_addc_u32 s17, s17, 0
    v_mul_u32_u24 v156, 3584, v2
    v_lshl_add_u32 v156, v1, 4, v156
    s_mul_i32 s54, s96, 14336
    s_lshl_b32 s39, s35, 9
    s_add_u32 s54, s54, s39
    s_add_u32 s54, s54, 139264
    v_lshrrev_b32 v83, 5, v0
    v_mul_u32_u24 v157, 7168, v83
    v_and_b32 v84, 31, v0
    v_lshl_add_u32 v157, v84, 4, v157
    v_add_u32 v157, s54, v157
    v_mul_u32_u24 v159, 896, v79
    v_lshl_add_u32 v159, v2, 1, v159
    s_lshl_b32 s54, s47, 1
    v_add_u32 v159, s54, v159
    s_lshl_b32 s54, s57, 3
    s_lshl_b32 s34, s57, 2
    s_add_u32 s34, s34, 24
    s_cmp_lt_u32 s57, 6
    s_cselect_b32 s54, s54, s34
    s_add_u32 s54, s54, s62
    s_min_u32 s54, s54, 55
    s_lshr_b32 s34, s54, 2
    s_lshl_b32 s34, s34, 7
    s_and_b32 s35, s54, 1
    s_lshl_b32 s35, s35, 6
    s_add_u32 s34, s34, s35
    s_bfe_u32 s35, s54, 0x10001
    s_lshl_b32 s35, s35, 2
    s_add_u32 s34, s34, s35
    s_mul_i32 s34, s34, 896
    s_lshl_b32 s35, s53, 8
    s_add_u32 s34, s34, s35
    s_add_u32 s18, s18, s34
    s_addc_u32 s19, s19, 0
    v_and_b32 v84, s60, v1
    v_mul_u32_u24 v160, 896, v2
    v_lshl_add_u32 v160, v84, 4, v160
    v_mul_u32_u24 v161, 14336, v2
    v_mul_u32_u24 v84, 7168, v79
    v_add_u32 v161, v161, v84
    v_and_b32 v84, 7, v0
    v_lshl_add_u32 v161, v84, 4, v161
    s_lshl_b32 s34, s54, 7
    s_add_u32 s34, s34, 139264
    v_add_u32 v161, s34, v161
    v_and_b32 v84, 1, v2
    v_lshlrev_b32 v84, 4, v84
    v_lshl_add_u32 v84, v1, 5, v84
    v_lshl_add_u32 v162, v83, 9, v84

s_waitcnt vmcnt(14)
v_add_u32 v3, 0x01010101, v3
ds_read_b128 v[8:11], v7 offset:47104
ds_read_b128 v[12:15], v7 offset:47168
ds_read_b128 v[16:19], v7 offset:47232
ds_read_b128 v[20:23], v7 offset:47296
s_waitcnt vmcnt(10)
ds_read_b64_tr_b16 v[24:25], v72 offset:32768
ds_read_b64_tr_b16 v[26:27], v72 offset:33280
ds_read_b64_tr_b16 v[28:29], v73 offset:32768
ds_read_b64_tr_b16 v[30:31], v73 offset:33280
ds_read_b64_tr_b16 v[32:33], v74 offset:32768
ds_read_b64_tr_b16 v[34:35], v74 offset:33280
ds_read_b64_tr_b16 v[36:37], v75 offset:32768
ds_read_b64_tr_b16 v[38:39], v75 offset:33280
s_waitcnt lgkmcnt(6)
v_mfma_f32_16x16x32_bf16 v[56:59], v[24:27], v[8:11], 0
s_waitcnt lgkmcnt(4)
v_mfma_f32_16x16x32_bf16 v[60:63], v[28:31], v[8:11], 0
s_waitcnt lgkmcnt(2)
v_mfma_f32_16x16x32_bf16 v[64:67], v[32:35], v[8:11], 0
s_waitcnt lgkmcnt(0)
v_mfma_f32_16x16x32_bf16 v[68:71], v[36:39], v[8:11], 0
s_waitcnt vmcnt(6)
ds_read_b64_tr_b16 v[40:41], v72 offset:36864
ds_read_b64_tr_b16 v[42:43], v72 offset:37376
ds_read_b64_tr_b16 v[44:45], v73 offset:36864
ds_read_b64_tr_b16 v[46:47], v73 offset:37376
ds_read_b64_tr_b16 v[48:49], v74 offset:36864
ds_read_b64_tr_b16 v[50:51], v74 offset:37376
ds_read_b64_tr_b16 v[52:53], v75 offset:36864
ds_read_b64_tr_b16 v[54:55], v75 offset:37376
s_waitcnt lgkmcnt(6)
v_mfma_f32_16x16x32_bf16 v[56:59], v[40:43], v[12:15], v[56:59]
s_waitcnt lgkmcnt(4)
v_mfma_f32_16x16x32_bf16 v[60:63], v[44:47], v[12:15], v[60:63]
s_waitcnt lgkmcnt(2)
v_mfma_f32_16x16x32_bf16 v[64:67], v[48:51], v[12:15], v[64:67]
s_waitcnt lgkmcnt(0)
v_mfma_f32_16x16x32_bf16 v[68:71], v[52:55], v[12:15], v[68:71]
s_waitcnt vmcnt(2)
ds_read_b64_tr_b16 v[24:25], v72 offset:40960
ds_read_b64_tr_b16 v[26:27], v72 offset:41472
ds_read_b64_tr_b16 v[28:29], v73 offset:40960
ds_read_b64_tr_b16 v[30:31], v73 offset:41472
ds_read_b64_tr_b16 v[32:33], v74 offset:40960
ds_read_b64_tr_b16 v[34:35], v74 offset:41472
ds_read_b64_tr_b16 v[36:37], v75 offset:40960
ds_read_b64_tr_b16 v[38:39], v75 offset:41472
s_waitcnt lgkmcnt(6)
v_mfma_f32_16x16x32_bf16 v[56:59], v[24:27], v[16:19], v[56:59]
s_waitcnt lgkmcnt(4)
v_mfma_f32_16x16x32_bf16 v[60:63], v[28:31], v[16:19], v[60:63]
s_waitcnt lgkmcnt(2)
v_mfma_f32_16x16x32_bf16 v[64:67], v[32:35], v[16:19], v[64:67]
s_waitcnt lgkmcnt(0)
v_mfma_f32_16x16x32_bf16 v[68:71], v[36:39], v[16:19], v[68:71]
s_waitcnt vmcnt(0)
v_and_b32 v72, 0xfffff7ff, v72
v_and_b32 v73, 0xfffff7ff, v73
v_and_b32 v74, 0xfffff7ff, v74
v_and_b32 v75, 0xfffff7ff, v75
s_waitcnt lgkmcnt(0)
v_cndmask_b32 v20, 0, v20, s[36:37]
v_cndmask_b32 v21, 0, v21, s[36:37]
v_cndmask_b32 v22, 0, v22, s[36:37]
v_cndmask_b32 v23, 0, v23, s[36:37]
ds_read_b64_tr_b16 v[40:41], v72 offset:45056
ds_read_b64_tr_b16 v[42:43], v72 offset:45568
ds_read_b64_tr_b16 v[44:45], v73 offset:45056
ds_read_b64_tr_b16 v[46:47], v73 offset:45568
ds_read_b64_tr_b16 v[48:49], v74 offset:45056
ds_read_b64_tr_b16 v[50:51], v74 offset:45568
ds_read_b64_tr_b16 v[52:53], v75 offset:45056
ds_read_b64_tr_b16 v[54:55], v75 offset:45568
s_waitcnt lgkmcnt(6)
v_mfma_f32_16x16x32_bf16 v[56:59], v[40:43], v[20:23], v[56:59]
s_waitcnt lgkmcnt(4)
v_mfma_f32_16x16x32_bf16 v[60:63], v[44:47], v[20:23], v[60:63]
s_waitcnt lgkmcnt(2)
v_mfma_f32_16x16x32_bf16 v[64:67], v[48:51], v[20:23], v[64:67]
s_waitcnt lgkmcnt(0)
v_mfma_f32_16x16x32_bf16 v[68:71], v[52:55], v[20:23], v[68:71]
    s_nop 3
v_cndmask_b32 v56, v56, v60, s[48:49]
    s_nop 2
v_cndmask_b32 v64, v64, v68, s[48:49]
v_cndmask_b32 v57, v57, v61, s[48:49]
v_cndmask_b32 v65, v65, v69, s[48:49]
v_cndmask_b32 v58, v58, v62, s[48:49]
v_cndmask_b32 v66, v66, v70, s[48:49]
v_cndmask_b32 v59, v59, v63, s[48:49]
v_cndmask_b32 v67, v67, v71, s[48:49]
v_cndmask_b32 v68, v56, v64, s[50:51]
v_cndmask_b32 v69, v57, v65, s[50:51]
v_cndmask_b32 v70, v58, v66, s[50:51]
v_cndmask_b32 v71, v59, v67, s[50:51]
v_perm_b32 v68, v68, v3, s40
v_perm_b32 v69, v69, v3, s41
v_perm_b32 v70, v70, v3, s42
v_perm_b32 v71, v71, v3, s43
s_mov_b32 exec_lo, 0x0f0f0f0f
s_mov_b32 exec_hi, 0x0f0f0f0f
global_store_dwordx4 v158, v[68:71], s[26:27]
    s_getreg_b32 s100, hwreg(HW_REG_XCC_ID)
    s_lshl_b32 s100, s100, 8
    s_lshl_b32 s39, s2, 7
    s_add_u32 s39, s39, 655360
    s_mov_b32 exec_lo, 0x00300030
    s_mov_b32 exec_hi, 0x00300030
    v_and_b32 v92, 1, v0
    v_lshl_add_u32 v92, v2, 1, v92
    v_lshlrev_b32 v92, 4, v92
    v_add_u32 v158, s39, v92
    v_mov_b32 v68, s100
    v_mov_b32 v69, s100
    v_mov_b32 v70, s100
    v_mov_b32 v71, s100

v_perm_b32 v68, v68, v3, s40
v_perm_b32 v69, v69, v3, s41
v_perm_b32 v70, v70, v3, s42
v_perm_b32 v71, v71, v3, s43
    s_mov_b32 exec_lo, 0x0f3f0f3f
    s_mov_b32 exec_hi, 0x0f3f0f3f
    global_store_dwordx4 v158, v[68:71], s[14:15] sc1

s_mov_b64 exec, -1
s_setprio 0
    v_mov_b32 v84, 0
    v_mov_b32 v85, 0
    s_mov_b32 exec_lo, -1
    s_mov_b32 exec_hi, 0x00ffffff
    ds_read_b128 v[8:11], v4 offset:47104
    ds_read_b128 v[12:15], v4 offset:48000
    ds_read_b128 v[16:19], v4 offset:49152
    s_waitcnt lgkmcnt(0)

v_dot2_f32_bf16 v84, v8, v16, v84
v_dot2_f32_bf16 v85, v12, v16, v85
v_dot2_f32_bf16 v84, v9, v17, v84
v_dot2_f32_bf16 v85, v13, v17, v85
v_dot2_f32_bf16 v84, v10, v18, v84
v_dot2_f32_bf16 v85, v14, v18, v85
v_dot2_f32_bf16 v84, v11, v19, v84
v_dot2_f32_bf16 v85, v15, v19, v85
s_mov_b64 exec, -1
ds_read_u16 v20, v159 offset:47104
ds_read_u16 v21, v159 offset:47112
ds_read_u16 v22, v159 offset:47120
ds_read_u16 v23, v159 offset:47128
ds_read_u16 v24, v159 offset:47136
ds_read_u16 v25, v159 offset:47144
ds_read_u16 v26, v159 offset:47152
v_add_f32_dpp v84, v84, v84 row_ror:8 row_mask:0xf bank_mask:0xf
v_add_f32_dpp v85, v85, v85 row_ror:8 row_mask:0xf bank_mask:0xf
    s_nop 0
v_add_f32_dpp v84, v84, v84 row_ror:4 row_mask:0xf bank_mask:0xf
v_add_f32_dpp v85, v85, v85 row_ror:4 row_mask:0xf bank_mask:0xf
    s_nop 0
v_add_f32_dpp v84, v84, v84 row_ror:2 row_mask:0xf bank_mask:0xf
v_add_f32_dpp v85, v85, v85 row_ror:2 row_mask:0xf bank_mask:0xf
    s_nop 0
v_add_f32_dpp v84, v84, v84 row_ror:1 row_mask:0xf bank_mask:0xf
v_add_f32_dpp v85, v85, v85 row_ror:1 row_mask:0xf bank_mask:0xf
v_mov_b32 v86, v84
    s_nop 1
v_permlane16_swap_b32 v86, v84
v_add_f32 v84, v84, v86
v_mov_b32 v86, v84
    s_nop 1
v_permlane32_swap_b32 v86, v84
v_add_f32 v84, v84, v86
v_mov_b32 v86, v85
    s_nop 1
v_permlane16_swap_b32 v86, v85
v_add_f32 v85, v85, v86
v_mov_b32 v86, v85
    s_nop 1
v_permlane32_swap_b32 v86, v85
v_add_f32 v85, v85, v86
    v_and_b32 v86, 1, v0
    v_cmp_eq_u32 vcc, 1, v86
    s_nop 1
    v_cndmask_b32 v84, v84, v85, vcc
    v_cvt_pk_bf16_f32 v84, v84, v84
    v_lshlrev_b32 v84, 16, v84
    v_mul_f32 v84, 0xbfb8aa3b, v84
    v_exp_f32 v84, v84
    s_nop 0
    v_add_f32 v84, 1.0, v84
    v_rcp_f32 v84, v84
    s_nop 0
    v_cvt_pk_bf16_f32 v84, v84, v84
    v_lshlrev_b32 v84, 16, v84
    v_sub_f32 v85, 1.0, v84
    v_cvt_pk_bf16_f32 v85, v85, v85
    v_lshlrev_b32 v85, 16, v85
    v_lshlrev_b32 v86, 2, v86
    s_mov_b64 exec, 3
    ds_write_b32 v86, v84 offset:51200
    s_mov_b64 exec, -1
    v_readlane_b32 s34, v85, 0
    v_readlane_b32 s35, v85, 1
    v_cmp_gt_u32 vcc, 32, v0
    s_nop 0
    v_mov_b32 v87, s35
    v_mov_b32 v88, s34
    v_cndmask_b32 v87, v87, v88, vcc
    s_waitcnt lgkmcnt(0)

v_lshl_or_b32 v20, v20, 16, v20
v_lshl_or_b32 v21, v21, 16, v21
v_lshl_or_b32 v22, v22, 16, v22
v_lshl_or_b32 v23, v23, 16, v23
v_lshl_or_b32 v24, v24, 16, v24
v_lshl_or_b32 v25, v25, 16, v25
v_lshl_or_b32 v26, v26, 16, v26
v_and_b32 v100, v20, v96
v_and_b32 v101, v20, v97
v_and_b32 v102, v20, v98
v_and_b32 v103, v20, v99
v_and_b32 v104, v21, v96
v_and_b32 v105, v21, v97
v_and_b32 v106, v21, v98
v_and_b32 v107, v21, v99
v_and_b32 v108, v22, v96
v_and_b32 v109, v22, v97
v_and_b32 v110, v22, v98
v_and_b32 v111, v22, v99
v_and_b32 v112, v23, v96
v_and_b32 v113, v23, v97
v_and_b32 v114, v23, v98
v_and_b32 v115, v23, v99
v_and_b32 v116, v24, v96
v_and_b32 v117, v24, v97
v_and_b32 v118, v24, v98
v_and_b32 v119, v24, v99
v_and_b32 v120, v25, v96
v_and_b32 v121, v25, v97
v_and_b32 v122, v25, v98
v_and_b32 v123, v25, v99
v_and_b32 v124, v26, v96
v_and_b32 v125, v26, v97
v_and_b32 v126, v26, v98
v_and_b32 v127, v26, v99
s_barrier
    v_and_b32 v92, 31, v0
    v_lshlrev_b32 v92, 10, v92
    s_lshl_b32 s39, s28, 7
    s_add_u32 s39, s39, 655360
    v_add_u32 v92, s39, v92
    global_load_dwordx4 v[164:167], v92, s[14:15] sc1

    s_cmp_eq_u32 s58, 0
    s_cbranch_scc1 L_a_none

global_load_dwordx4 v[128:131], v156, s[16:17] nt
s_add_u32 s16, s16, 14336
s_addc_u32 s17, s17, 0
global_load_dwordx4 v[132:135], v156, s[16:17] nt
s_add_u32 s16, s16, 14336
s_addc_u32 s17, s17, 0
global_load_dwordx4 v[136:139], v156, s[16:17] nt
s_add_u32 s16, s16, 14336
s_addc_u32 s17, s17, 0
global_load_dwordx4 v[140:143], v156, s[16:17] nt
s_add_u32 s16, s16, 14336
s_addc_u32 s17, s17, 0
global_load_dwordx4 v[144:147], v156, s[16:17] nt
s_add_u32 s16, s16, 14336
s_addc_u32 s17, s17, 0
global_load_dwordx4 v[148:151], v156, s[16:17] nt
s_add_u32 s16, s16, 14336
s_addc_u32 s17, s17, 0
global_load_dwordx4 v[152:155], v156, s[16:17] nt
global_load_dwordx4 v[8:11], v160, s[18:19] nt
s_add_u32 s18, s18, 7168
s_addc_u32 s19, s19, 0
global_load_dwordx4 v[12:15], v160, s[18:19] nt
s_add_u32 s18, s18, 7168
s_addc_u32 s19, s19, 0
global_load_dwordx4 v[16:19], v160, s[18:19] nt
s_add_u32 s18, s18, 7168
s_addc_u32 s19, s19, 0
global_load_dwordx4 v[20:23], v160, s[18:19] nt
s_add_u32 s18, s18, 7168
s_addc_u32 s19, s19, 0
global_load_dwordx4 v[24:27], v160, s[18:19] nt
s_add_u32 s18, s18, 7168
s_addc_u32 s19, s19, 0
global_load_dwordx4 v[28:31], v160, s[18:19] nt
s_add_u32 s18, s18, 7168
s_addc_u32 s19, s19, 0
global_load_dwordx4 v[32:35], v160, s[18:19] nt
s_add_u32 s18, s18, 7168
s_addc_u32 s19, s19, 0
global_load_dwordx4 v[36:39], v160, s[18:19] nt
s_waitcnt vmcnt(15)
v_perm_b32 v88, v165, v164, s44
v_perm_b32 v89, v167, v166, s45
v_bitop3_b32 v90, v88, v89, v3 bitop3:0x56
    v_lshrrev_b32 v91, 8, v164
    s_lshr_b32 s39, s100, 8
    v_xor_b32 v91, s39, v91
    v_or_b32 v90, v90, v91
    v_cmp_ne_u32 vcc, 0, v90
    s_nop 0
    s_cmp_eq_u64 vcc, 0
    s_cselect_b32 s100, 1, 0
    v_mov_b32 v90, s100
    v_mov_b32 v91, 0
    ds_write_b32 v91, v90 offset:51280
    s_waitcnt lgkmcnt(0)

s_barrier
s_waitcnt vmcnt(8)
v_mfma_f32_16x16x32_bf16 v[68:71], v[100:103], v[128:131], 0
v_mfma_f32_16x16x32_bf16 v[68:71], v[104:107], v[132:135], v[68:71]
v_mfma_f32_16x16x32_bf16 v[68:71], v[108:111], v[136:139], v[68:71]
v_mfma_f32_16x16x32_bf16 v[68:71], v[112:115], v[140:143], v[68:71]
v_mfma_f32_16x16x32_bf16 v[68:71], v[116:119], v[144:147], v[68:71]
v_mfma_f32_16x16x32_bf16 v[68:71], v[120:123], v[148:151], v[68:71]
v_mfma_f32_16x16x32_bf16 v[68:71], v[124:127], v[152:155], v[68:71]
    s_nop 7
v_perm_b32 v68, v68, v3, s40
v_perm_b32 v69, v69, v3, s41
v_perm_b32 v70, v70, v3, s42
v_perm_b32 v71, v71, v3, s43
global_store_dwordx4 v157, v[68:71], s[26:27]
s_cmp_lg_u32 s100, 0
s_cbranch_scc1 L_skipb_hpub
global_store_dwordx4 v157, v[68:71], s[14:15] sc1
L_skipb_hpub:
s_waitcnt vmcnt(1)
v_add_u32 v88, 0, v161
global_load_dwordx4 v[40:43], v88, s[26:27] sc1
v_add_u32 v88, 57344, v161
global_load_dwordx4 v[44:47], v88, s[26:27] sc1
v_add_u32 v88, 114688, v161
global_load_dwordx4 v[48:51], v88, s[26:27] sc1
v_add_u32 v88, 172032, v161
global_load_dwordx4 v[52:55], v88, s[26:27] sc1
s_waitcnt vmcnt(0)
v_perm_b32 v80, v41, v40, s44
v_perm_b32 v81, v43, v42, s45
v_bitop3_b32 v76, v80, v81, v3 bitop3:0x56
v_perm_b32 v80, v45, v44, s44
v_perm_b32 v81, v47, v46, s45
v_bitop3_b32 v77, v80, v81, v3 bitop3:0x56
v_perm_b32 v80, v49, v48, s44
v_perm_b32 v81, v51, v50, s45
v_bitop3_b32 v78, v80, v81, v3 bitop3:0x56
v_perm_b32 v80, v53, v52, s44
v_perm_b32 v81, v55, v54, s45
v_bitop3_b32 v79, v80, v81, v3 bitop3:0x56
v_or3_b32 v76, v76, v77, v78
v_or_b32 v76, v76, v79
    v_cmp_ne_u32 vcc, 0, v76
    s_cbranch_vccz L_ah_ok

L_ah_r:
    s_sub_u32 s46, s46, 1
    s_cmp_eq_u32 s46, 0
    s_cbranch_scc1 L_ah_ok
    s_mov_b64 exec, vcc

    s_and_b32 s32, s46, 15
    s_cmp_eq_u32 s32, 0
    s_cbranch_scc1 L_ah_r_b

v_add_u32 v88, 0, v161
global_load_dwordx4 v[40:43], v88, s[26:27] sc1
v_add_u32 v88, 57344, v161
global_load_dwordx4 v[44:47], v88, s[26:27] sc1
v_add_u32 v88, 114688, v161
global_load_dwordx4 v[48:51], v88, s[26:27] sc1
v_add_u32 v88, 172032, v161
global_load_dwordx4 v[52:55], v88, s[26:27] sc1
s_branch L_ah_r_c
L_ah_r_b:
v_add_u32 v88, 0, v161
global_load_dwordx4 v[40:43], v88, s[14:15] sc1
v_add_u32 v88, 57344, v161
global_load_dwordx4 v[44:47], v88, s[14:15] sc1
v_add_u32 v88, 114688, v161
global_load_dwordx4 v[48:51], v88, s[14:15] sc1
v_add_u32 v88, 172032, v161
global_load_dwordx4 v[52:55], v88, s[14:15] sc1
L_ah_r_c:
s_waitcnt vmcnt(0)
v_perm_b32 v80, v41, v40, s44
v_perm_b32 v81, v43, v42, s45
v_bitop3_b32 v76, v80, v81, v3 bitop3:0x56
v_perm_b32 v80, v45, v44, s44
v_perm_b32 v81, v47, v46, s45
v_bitop3_b32 v77, v80, v81, v3 bitop3:0x56
v_perm_b32 v80, v49, v48, s44
v_perm_b32 v81, v51, v50, s45
v_bitop3_b32 v78, v80, v81, v3 bitop3:0x56
v_perm_b32 v80, v53, v52, s44
v_perm_b32 v81, v55, v54, s45
v_bitop3_b32 v79, v80, v81, v3 bitop3:0x56
v_or3_b32 v76, v76, v77, v78
v_or_b32 v76, v76, v79
    v_cmp_ne_u32 vcc, 0, v76
    s_cbranch_vccnz L_ah_r

L_ah_ok:
s_mov_b64 exec, -1
v_and_b32 v40, s101, v40
v_and_b32 v41, s101, v41
v_and_b32 v42, s101, v42
v_and_b32 v43, s101, v43
v_and_b32 v44, s101, v44
v_and_b32 v45, s101, v45
v_and_b32 v46, s101, v46
v_and_b32 v47, s101, v47
v_and_b32 v48, s101, v48
v_and_b32 v49, s101, v49
v_and_b32 v50, s101, v50
v_and_b32 v51, s101, v51
v_and_b32 v52, s101, v52
v_and_b32 v53, s101, v53
v_and_b32 v54, s101, v54
v_and_b32 v55, s101, v55
    v_pk_add_f32 v[40:41], v[40:41], v[44:45]
    v_pk_add_f32 v[42:43], v[42:43], v[46:47]
    v_pk_add_f32 v[48:49], v[48:49], v[52:53]
    v_pk_add_f32 v[50:51], v[50:51], v[54:55]
    v_pk_add_f32 v[40:41], v[40:41], v[48:49]
    v_pk_add_f32 v[42:43], v[42:43], v[50:51]
    s_nop 1
    v_permlane32_swap_b32 v40, v42
    v_permlane32_swap_b32 v41, v43
    v_add_f32 v40, v40, v42
    v_add_f32 v41, v41, v43
    s_nop 1
    v_permlane16_swap_b32 v40, v41
    v_add_f32 v40, v40, v41
    v_max_f32 v40, 0, v40
    v_cvt_pk_bf16_f32 v40, v40, v40

    s_nop 1
v_mov_b32_dpp v41, v40 row_newbcast:0 row_mask:0xf bank_mask:0x3
v_mov_b32_dpp v41, v40 row_newbcast:8 row_mask:0xf bank_mask:0xc
v_and_b32 v56, v41, v96
v_and_b32 v57, v41, v97
v_and_b32 v58, v41, v98
v_and_b32 v59, v41, v99
s_waitcnt vmcnt(12)
    s_nop 0
v_mfma_f32_16x16x32_bf16 v[72:75], v[56:59], v[8:11], 0
v_mov_b32_dpp v42, v40 row_newbcast:1 row_mask:0xf bank_mask:0x3
v_mov_b32_dpp v42, v40 row_newbcast:9 row_mask:0xf bank_mask:0xc
v_and_b32 v60, v42, v96
v_and_b32 v61, v42, v97
v_and_b32 v62, v42, v98
v_and_b32 v63, v42, v99
s_waitcnt vmcnt(11)
    s_nop 0
v_mfma_f32_16x16x32_bf16 v[72:75], v[60:63], v[12:15], v[72:75]
v_mov_b32_dpp v41, v40 row_newbcast:2 row_mask:0xf bank_mask:0x3
v_mov_b32_dpp v41, v40 row_newbcast:10 row_mask:0xf bank_mask:0xc
v_and_b32 v56, v41, v96
v_and_b32 v57, v41, v97
v_and_b32 v58, v41, v98
v_and_b32 v59, v41, v99
s_waitcnt vmcnt(10)
    s_nop 0
v_mfma_f32_16x16x32_bf16 v[72:75], v[56:59], v[16:19], v[72:75]
v_mov_b32_dpp v42, v40 row_newbcast:3 row_mask:0xf bank_mask:0x3
v_mov_b32_dpp v42, v40 row_newbcast:11 row_mask:0xf bank_mask:0xc
v_and_b32 v60, v42, v96
v_and_b32 v61, v42, v97
v_and_b32 v62, v42, v98
v_and_b32 v63, v42, v99
s_waitcnt vmcnt(9)
    s_nop 0
v_mfma_f32_16x16x32_bf16 v[72:75], v[60:63], v[20:23], v[72:75]
v_mov_b32_dpp v41, v40 row_newbcast:4 row_mask:0xf bank_mask:0x3
v_mov_b32_dpp v41, v40 row_newbcast:12 row_mask:0xf bank_mask:0xc
v_and_b32 v56, v41, v96
v_and_b32 v57, v41, v97
v_and_b32 v58, v41, v98
v_and_b32 v59, v41, v99
s_waitcnt vmcnt(8)
    s_nop 0
v_mfma_f32_16x16x32_bf16 v[72:75], v[56:59], v[24:27], v[72:75]
v_mov_b32_dpp v42, v40 row_newbcast:5 row_mask:0xf bank_mask:0x3
v_mov_b32_dpp v42, v40 row_newbcast:13 row_mask:0xf bank_mask:0xc
v_and_b32 v60, v42, v96
v_and_b32 v61, v42, v97
v_and_b32 v62, v42, v98
v_and_b32 v63, v42, v99
s_waitcnt vmcnt(7)
    s_nop 0
v_mfma_f32_16x16x32_bf16 v[72:75], v[60:63], v[28:31], v[72:75]
v_mov_b32_dpp v41, v40 row_newbcast:6 row_mask:0xf bank_mask:0x3
v_mov_b32_dpp v41, v40 row_newbcast:14 row_mask:0xf bank_mask:0xc
v_and_b32 v56, v41, v96
v_and_b32 v57, v41, v97
v_and_b32 v58, v41, v98
v_and_b32 v59, v41, v99
s_waitcnt vmcnt(6)
    s_nop 0
v_mfma_f32_16x16x32_bf16 v[72:75], v[56:59], v[32:35], v[72:75]
v_mov_b32_dpp v42, v40 row_newbcast:7 row_mask:0xf bank_mask:0x3
v_mov_b32_dpp v42, v40 row_newbcast:15 row_mask:0xf bank_mask:0xc
v_and_b32 v60, v42, v96
v_and_b32 v61, v42, v97
v_and_b32 v62, v42, v98
v_and_b32 v63, v42, v99
s_waitcnt vmcnt(5)
    s_nop 0
v_mfma_f32_16x16x32_bf16 v[72:75], v[60:63], v[36:39], v[72:75]
    s_nop 7
v_mul_f32 v72, v87, v72
v_mul_f32 v73, v87, v73
v_mul_f32 v74, v87, v74
v_mul_f32 v75, v87, v75
L_a_wr:
    ds_write_b128 v162, v[72:75] offset:32768
    s_waitcnt lgkmcnt(0)

    s_barrier
    s_branch L_fin
L_a_none:
    v_mov_b32 v72, 0
    v_mov_b32 v73, 0
    v_mov_b32 v74, 0
    v_mov_b32 v75, 0

s_waitcnt vmcnt(0)
v_perm_b32 v88, v165, v164, s44
v_perm_b32 v89, v167, v166, s45
v_bitop3_b32 v90, v88, v89, v3 bitop3:0x56
    v_lshrrev_b32 v91, 8, v164
    s_lshr_b32 s39, s100, 8
    v_xor_b32 v91, s39, v91
    v_or_b32 v90, v90, v91
    v_cmp_ne_u32 vcc, 0, v90
    s_nop 0
    s_cmp_eq_u64 vcc, 0
    s_cselect_b32 s100, 1, 0
    v_mov_b32 v90, s100
    v_mov_b32 v91, 0
    ds_write_b32 v91, v90 offset:51280
    s_waitcnt lgkmcnt(0)

    s_barrier
    s_branch L_a_wr

L_fin:
L_end:
    s_endpgm

.section .rodata,"a"
.p2align 6
.amdhsa_kernel gated_mix__sliding_block_cached__dense_activation_relu__decode_kernel
  .amdhsa_next_free_vgpr 168
  .amdhsa_next_free_sgpr 102
  .amdhsa_accum_offset 168
  .amdhsa_group_segment_fixed_size 0
  .amdhsa_kernarg_size 96
  .amdhsa_user_sgpr_count 2
  .amdhsa_user_sgpr_kernarg_segment_ptr 1
  .amdhsa_system_sgpr_workgroup_id_x 1
.end_amdhsa_kernel
```
